```python
import torch

def _softmax(x, axis=-1):
    return torch.softmax(x, dim=axis)
def _gelu(x):
    return torch.nn.functional.gelu(x, approximate="tanh")
def _silu(x):
    return torch.nn.functional.silu(x)
def _sigmoid(x):
    return torch.sigmoid(x)
def _layernorm(x, axis=-1, eps=1e-5):
    m = x.mean(dim=axis, keepdim=True)
    v = x.var(dim=axis, keepdim=True, unbiased=False)
    return (x - m) / torch.sqrt(v + eps)
def _scatter_add(tgt, idx, src, axis=0):
    return tgt.clone().index_add_(axis, idx, src)
def _segment_sum(src, seg, n):
    out = torch.zeros((n,) + src.shape[1:], dtype=src.dtype)
    return out.index_add_(0, seg, src)
def _pad(x, pw):
    flat = tuple(v for pair in reversed(pw) for v in pair)
    return torch.nn.functional.pad(x, flat)

kernel_name = 'gated_mix__sliding_block_cached__glu_gated_swiglu__decode'

def setup_inputs():

    _w = (lambda a: (lambda t: t.to(torch.bfloat16) if t.is_floating_point() else t)(torch.as_tensor(a)))
    def _A_setup():
        B, Sq, D = 4, 1, 512
        Hq, Hkv, Sk, Dh = 32, 8, 8192, 128
        assert Hq % Hkv == 0, (Hq, Hkv)
        return {
            "x": _w((lambda *s: torch.randn(*s, dtype=torch.bfloat16) * 0.05)(B, Sq, D)),
            "k_cache": _w((lambda *s: torch.randn(*s, dtype=torch.bfloat16) * 6.4)(B, Hkv, Sk, Dh)),
            "v_cache": _w((lambda *s: torch.randn(*s, dtype=torch.bfloat16) * 0.05)(B, Hkv, Sk, Dh)),
            "wq": _w((lambda *s: torch.randn(*s, dtype=torch.bfloat16) * 6.4)(D, Hq * Dh) * (D ** -0.5)),
            "wo": _w((lambda *s: torch.randn(*s, dtype=torch.bfloat16) * 0.05)(Hq * Dh, D) * ((Hq * Dh) ** -0.5)),
        }
    _A_in = _A_setup()

    def _B_setup():
        B, S, D, F = 4, 1, 512, 1792
        return {
            "x": _w((lambda *s: torch.randn(*s, dtype=torch.bfloat16) * 0.05)(B, S, D)),
            "w1": _w((lambda *s: torch.randn(*s, dtype=torch.bfloat16) * 0.4)(D, F) * (2.0 / D) ** 0.5),
            "w3": _w((lambda *s: torch.randn(*s, dtype=torch.bfloat16) * 0.4)(D, F) * (2.0 / D) ** 0.5),
            "w2": _w((lambda *s: torch.randn(*s, dtype=torch.bfloat16) * 0.4)(F, D) * (2.0 / F) ** 0.5),
        }
    _B_in = _B_setup()

    return {
        "A_x": _A_in["x"],
        "A_k_cache": _A_in["k_cache"],
        "A_v_cache": _A_in["v_cache"],
        "A_wq": _A_in["wq"],
        "A_wo": _A_in["wo"],
        "B_x": _B_in["x"],
        "B_w1": _B_in["w1"],
        "B_w3": _B_in["w3"],
        "B_w2": _B_in["w2"],
        "gate_w": _w((lambda *s: torch.randn(*s, dtype=torch.bfloat16) * 0.05)(512) * 16.0),
    }

def reference(A_x, A_k_cache, A_v_cache, A_wq, A_wo, B_x, B_w1, B_w3, B_w2, gate_w):
    def _A_ref(x, k_cache, v_cache, wq, wo):
        B, Sq, D = x.shape
        Hq, Dh = 32, 128
        Hkv, Sk = k_cache.shape[1], k_cache.shape[2]
        W = min(4096, max(256, Sk // 4))
        rep = Hq // Hkv
        q = (lambda x, *d: x.permute(*d))((x @ wq).reshape(B, Sq, Hq, Dh), 0, 2, 1, 3)
        k = (lambda x, n, axis: torch.repeat_interleave(x, n, dim=axis))(k_cache[:, :, Sk - W:, :], rep, axis=1)
        v = (lambda x, n, axis: torch.repeat_interleave(x, n, dim=axis))(v_cache[:, :, Sk - W:, :], rep, axis=1)
        scores = torch.einsum("bhqd,bhkd->bhqk", q, k) * (Dh ** -0.5)
        p = _softmax(scores, axis=-1)
        o = torch.einsum("bhqk,bhkd->bhqd", p, v)
        return (lambda x, *d: x.permute(*d))(o, 0, 2, 1, 3).reshape(B, Sq, Hq * Dh) @ wo

    def _B_ref(x, w1, w3, w2):
        gate = torch.einsum("bsd,df->bsf", x, w1)
        up = torch.einsum("bsd,df->bsf", x, w3)
        h = _silu(gate) * up
        out = torch.einsum("bsf,fd->bsd", h, w2)
        return out

    x = A_x
    g = _sigmoid((x * gate_w).sum(-1, keepdims=True))
    a = _A_ref(x, A_k_cache, A_v_cache, A_wq, A_wo)
    b = _B_ref(x, B_w1, B_w3, B_w2)
    return g * a + (1 - g) * b
```

```asm
; @launch grid=(256,1,1) block=(512,1,1) lds=163840
.amdgcn_target "amdgcn-amd-amdhsa--gfx950"
.text
.globl gated_mix__sliding_block_cached__glu_gated_swiglu__decode_kernel
.p2align 8
.type gated_mix__sliding_block_cached__glu_gated_swiglu__decode_kernel,@function
gated_mix__sliding_block_cached__glu_gated_swiglu__decode_kernel:
  s_cmp_ge_u32 s2, 256
  s_cbranch_scc1 L_end
  s_load_dwordx16 s[16:31], s[0:1], 0
  s_load_dwordx8 s[32:39], s[0:1], 64
  s_load_dwordx2 s[40:41], s[0:1], 96
  v_lshrrev_b32 v1, 6, v0
  v_and_b32 v0, 63, v0
  v_readfirstlane_b32 s3, v1
  v_and_b32 v1, 15, v0
  v_lshrrev_b32 v2, 4, v0
  v_and_b32 v3, 3, v0
  v_lshrrev_b32 v58, 2, v1
  s_and_b32 s4, s2, 7
  s_lshr_b32 s5, s2, 3
  s_lshr_b32 s6, s5, 3
  s_and_b32 s7, s5, 7
  v_mov_b32 v62, 155648
  v_mov_b32 v63, 1
  s_mov_b32 s51, 0x00020000
  s_mov_b32 s55, 0x00020000
  s_cmp_ge_u32 s3, 4
  s_cbranch_scc1 L_GB
  s_add_u32 s10, s5, 0
  s_and_b32 s10, s10, 15
  s_lshl_b32 s9, s4, 4
  s_add_u32 s9, s9, s10
  s_mul_i32 s10, s4, 14
  s_add_u32 s10, s10, s5
  s_add_u32 s10, s10, 112
  s_cmp_ge_u32 s5, 16
  s_cselect_b32 s9, s10, s9
  s_movk_i32 s12, 8192
  s_movk_i32 s13, 3584
  s_mov_b32 s14, 4194304
  s_mov_b32 s15, 1835008
  s_cselect_b32 s12, s13, s12
  s_cselect_b32 s14, s15, s14
  s_cselect_b32 s10, 128, 0
  s_cmp_ge_u32 s9, 184
  s_cselect_b32 s10, 184, s10
  s_sub_u32 s10, s9, s10
  s_and_b32 s11, s10, 1
  s_lshr_b32 s10, s10, 1
  s_lshl_b32 s10, s10, 7
  s_lshl_b32 s13, s12, 8
  s_mul_i32 s13, s13, s11
  s_add_u32 s10, s10, s13
  s_sub_u32 s50, s14, s10
  s_cmp_ge_u32 s5, 30
  s_cselect_b32 s50, 0, s50
  s_cselect_b32 s9, 255, s9
  v_lshrrev_b32 v6, 3, v0
  v_mul_lo_u32 v6, v6, s12
  v_and_b32 v8, 7, v0
  v_bfe_u32 v9, v0, 4, 1
  v_lshlrev_b32 v9, 1, v9
  v_xor_b32 v8, v8, v9
  v_lshl_add_u32 v6, v8, 4, v6
  v_xor_b32 v7, 64, v6
  s_lshl_b32 s15, s12, 6
  s_mul_i32 s15, s15, s3
  s_lshl_b32 s13, s12, 3
  s_lshl_b32 s14, s3, 13
  s_add_u32 s14, s14, 98304
  s_mov_b32 m0, s14
  s_add_u32 s14, s14, 8192
  v_lshlrev_b32 v8, 10, v3
  v_lshl_add_u32 v8, v2, 4, v8
  v_lshlrev_b32 v9, 4, v2
  v_mov_b32 v4, 0
  v_lshlrev_b32 v172, 4, v0
  s_lshl_b32 s60, s11, 9
  s_lshl_b32 s61, s3, 7
  s_add_u32 s60, s60, s61
  s_lshl_b32 s61, s3, 8
  s_mov_b32 s46, 2228224
  s_mov_b32 s47, 0x00020000
  s_mov_b32 s54, 4096
  s_mov_b32 s58, 1024
  s_mov_b32 s59, 0x00020000
  s_waitcnt lgkmcnt(0)
  s_mov_b32 s44, s40
  s_mov_b32 s45, s41
  s_mov_b32 s52, s16
  s_mov_b32 s53, s17
  s_mov_b32 s56, s34
  s_mov_b32 s57, s35
  buffer_load_dword v5, v4, s[44:47], 0 offen sc1
  s_mov_b32 exec_lo, 0x000F000F
  s_mov_b32 exec_hi, 0x000F000F
  buffer_load_dwordx4 v[64:67], v8, s[52:55], s60 offen offset:0
  buffer_load_dwordx4 v[68:71], v8, s[52:55], s60 offen offset:64
  buffer_load_dwordx4 v[72:75], v8, s[52:55], s61 offen offset:0
  buffer_load_dwordx4 v[76:79], v8, s[52:55], s61 offen offset:64
  buffer_load_dwordx4 v[80:83], v8, s[52:55], s61 offen offset:128
  buffer_load_dwordx4 v[84:87], v8, s[52:55], s61 offen offset:192
  s_mov_b32 exec_lo, 0x00010001
  s_mov_b32 exec_hi, 0x00010001
  buffer_load_dwordx4 v[88:91], v9, s[56:59], s61 offen offset:0
  buffer_load_dwordx4 v[92:95], v9, s[56:59], s61 offen offset:64
  buffer_load_dwordx4 v[96:99], v9, s[56:59], s61 offen offset:128
  buffer_load_dwordx4 v[100:103], v9, s[56:59], s61 offen offset:192
  s_mov_b64 exec, -1
  s_cmp_ge_u32 s9, 128
  s_cselect_b32 s48, s28, s22
  s_cselect_b32 s49, s29, s23
  s_cmp_ge_u32 s9, 184
  s_cselect_b32 s48, s30, s48
  s_cselect_b32 s49, s31, s49
  s_add_u32 s48, s48, s10
  s_addc_u32 s49, s49, 0
L_W1:
  buffer_load_dwordx4 v6, s[48:51], s15 offen nt lds
  s_add_u32 s15, s15, s13
  s_add_u32 m0, m0, 1024
  s_nop 0
  buffer_load_dwordx4 v7, s[48:51], s15 offen nt lds
  s_add_u32 s15, s15, s13
  s_add_u32 m0, m0, 1024
  s_cmp_lt_u32 m0, s14
  s_cbranch_scc1 L_W1
  s_barrier
  v_lshl_add_u32 v9, v2, 3, v58
  v_lshlrev_b32 v9, 7, v9
  v_bfe_u32 v10, v1, 3, 1
  v_and_b32 v11, 1, v2
  v_lshl_add_u32 v10, v11, 1, v10
  v_lshl_add_u32 v9, v10, 5, v9
  v_lshl_add_u32 v9, v3, 3, v9
  s_lshl_b32 s14, s3, 13
  s_add_u32 s14, s14, 98304
  v_add_u32 v10, s14, v9
  v_xor_b32 v11, 32, v10
  v_xor_b32 v12, 64, v10
  v_xor_b32 v13, 96, v10
  v_lshlrev_b32 v8, 6, v2
  v_lshl_add_u32 v8, v1, 4, v8
  s_mul_i32 s10, s3, 1280
  s_add_u32 s10, s10, 157184
  v_add_u32 v8, s10, v8
  s_add_u32 s98, s40, 4194304
  s_addc_u32 s99, s41, 0
  s_mov_b32 s52, s98
  s_mov_b32 s53, s99
  s_mov_b32 s54, 2228224
  s_mov_b32 s58, 2228224
  s_mov_b32 s101, 0
  s_lshl_b32 s100, s9, 11
  s_add_u32 s100, s100, 4096
  s_waitcnt vmcnt(0)
  ds_read_b64_tr_b16 v[104:105], v10 offset:0
  ds_read_b64_tr_b16 v[106:107], v10 offset:512
  ds_read_b64_tr_b16 v[108:109], v11 offset:0
  ds_read_b64_tr_b16 v[110:111], v11 offset:512
  ds_read_b64_tr_b16 v[112:113], v12 offset:0
  ds_read_b64_tr_b16 v[114:115], v12 offset:512
  ds_read_b64_tr_b16 v[116:117], v13 offset:0
  ds_read_b64_tr_b16 v[118:119], v13 offset:512
  ds_read_b64_tr_b16 v[120:121], v10 offset:4096
  ds_read_b64_tr_b16 v[122:123], v10 offset:4608
  ds_read_b64_tr_b16 v[124:125], v11 offset:4096
  ds_read_b64_tr_b16 v[126:127], v11 offset:4608
  ds_read_b64_tr_b16 v[128:129], v12 offset:4096
  ds_read_b64_tr_b16 v[130:131], v12 offset:4608
  ds_read_b64_tr_b16 v[132:133], v13 offset:4096
  ds_read_b64_tr_b16 v[134:135], v13 offset:4608
  v_mfma_f32_16x16x32_bf16 v[32:35], v[88:91], v[72:75], 0
  v_mfma_f32_16x16x32_bf16 v[32:35], v[92:95], v[76:79], v[32:35]
  v_mfma_f32_16x16x32_bf16 v[32:35], v[96:99], v[80:83], v[32:35]
  v_mfma_f32_16x16x32_bf16 v[32:35], v[100:103], v[84:87], v[32:35]
  v_readfirstlane_b32 s8, v5
  s_add_u32 s8, s8, 1
  s_mul_i32 s8, s8, 0x9e3779b1
  s_waitcnt lgkmcnt(8)
  v_mfma_f32_16x16x32_bf16 v[16:19], v[104:107], v[64:67], 0
  v_mfma_f32_16x16x32_bf16 v[20:23], v[108:111], v[64:67], 0
  v_mfma_f32_16x16x32_bf16 v[24:27], v[112:115], v[64:67], 0
  v_mfma_f32_16x16x32_bf16 v[28:31], v[116:119], v[64:67], 0
  s_waitcnt lgkmcnt(0)
  v_mfma_f32_16x16x32_bf16 v[16:19], v[120:123], v[68:71], v[16:19]
  v_mfma_f32_16x16x32_bf16 v[20:23], v[124:127], v[68:71], v[20:23]
  v_mfma_f32_16x16x32_bf16 v[24:27], v[128:131], v[68:71], v[24:27]
  v_mfma_f32_16x16x32_bf16 v[28:31], v[132:135], v[68:71], v[28:31]
  s_nop 5
  s_mov_b32 exec_lo, 0x000F000F
  s_mov_b32 exec_hi, 0x000F000F
  ds_write_b128 v8, v[16:19] offset:0
  ds_write_b128 v8, v[20:23] offset:256
  ds_write_b128 v8, v[24:27] offset:512
  ds_write_b128 v8, v[28:31] offset:768
  ds_write_b128 v8, v[32:35] offset:1024
  s_mov_b64 exec, 1
  s_waitcnt lgkmcnt(0)
  ds_add_rtn_u32 v11, v62, v63
  s_mov_b64 exec, -1
  v_bfe_u32 v8, v0, 3, 2
  v_lshlrev_b32 v8, 8, v8
  v_bfe_u32 v10, v0, 1, 2
  v_lshl_add_u32 v8, v10, 6, v8
  v_lshrrev_b32 v10, 5, v0
  v_lshl_add_u32 v8, v10, 4, v8
  v_and_b32 v10, 1, v0
  v_lshl_add_u32 v8, v10, 3, v8
  v_add_u32 v8, 157184, v8
  v_lshlrev_b32 v9, 4, v3
  v_add_u32 v9, 158208, v9
  v_mov_b32 v165, s8
  v_mov_b32 v167, s8
  v_mov_b32 v169, s8
  v_mov_b32 v171, s8
  s_waitcnt lgkmcnt(0)
  v_readfirstlane_b32 s10, v11
  s_cmp_lg_u32 s10, 3
  s_cbranch_scc1 L_QP
  ds_read_b64 v[16:17], v8 offset:0
  ds_read_b64 v[18:19], v8 offset:1280
  ds_read_b64 v[20:21], v8 offset:2560
  ds_read_b64 v[22:23], v8 offset:3840
  ds_read_b64 v[24:25], v8 offset:32
  ds_read_b64 v[26:27], v8 offset:1312
  ds_read_b64 v[28:29], v8 offset:2592
  ds_read_b64 v[30:31], v8 offset:3872
  ds_read_b32 v32, v9 offset:0
  ds_read_b32 v33, v9 offset:1280
  ds_read_b32 v34, v9 offset:2560
  ds_read_b32 v35, v9 offset:3840
  s_waitcnt lgkmcnt(4)
  v_add_f32 v16, v16, v18
  v_add_f32 v17, v17, v19
  v_add_f32 v20, v20, v22
  v_add_f32 v21, v21, v23
  v_add_f32 v24, v24, v26
  v_add_f32 v25, v25, v27
  v_add_f32 v28, v28, v30
  v_add_f32 v29, v29, v31
  v_add_f32 v164, v16, v20
  v_add_f32 v166, v17, v21
  v_add_f32 v168, v24, v28
  v_add_f32 v170, v25, v29
  s_cmp_ge_u32 s9, 128
  s_cbranch_scc1 L_NOA1
  s_mov_b32 s101, 1
  buffer_store_dwordx4 v[164:167], v172, s[52:55], s100 offen
  buffer_store_dwordx4 v[168:171], v172, s[52:55], s100 offen offset:1024
  s_branch L_NOA2
L_NOA1:
  buffer_store_dwordx4 v[164:167], v172, s[44:47], s100 offen sc1
  buffer_store_dwordx4 v[168:171], v172, s[44:47], s100 offen offset:1024 sc1
L_NOA2:
  s_waitcnt lgkmcnt(0)
  v_add_f32 v32, v32, v33
  v_add_f32 v34, v34, v35
  v_add_f32 v32, v32, v34
  v_mul_f32 v32, 0xbfb8aa3b, v32
  v_exp_f32 v32, v32
  v_lshlrev_b32 v9, 2, v0
  v_add_f32 v32, 1.0, v32
  v_rcp_f32 v32, v32
  v_add_u32 v9, 155680, v9
  s_mov_b64 exec, 15
  ds_write_b32 v9, v32
  s_mov_b64 exec, -1
L_QP:
  v_lshrrev_b32 v9, 5, v0
  v_lshlrev_b32 v9, 12, v9
  v_and_b32 v10, 31, v0
  v_lshl_add_u32 v9, v10, 4, v9
  s_lshl_b32 s10, s4, 4
  s_lshl_b32 s11, s3, 2
  s_add_u32 s10, s10, s11
  s_lshl_b32 s10, s10, 11
  s_lshl_b32 s11, s6, 9
  s_add_u32 s10, s10, s11
  s_add_u32 s10, s10, 4096
  s_mov_b32 s62, 20015
  s_sleep 2
Lpoll_q_1:
  s_cmp_lg_u32 s62, 20012
  s_cbranch_scc1 Lnb_q_4
  s_cmp_eq_u32 s101, 0
  s_cbranch_scc1 Lnb_q_4
  s_mov_b64 s[60:61], exec
  s_mov_b64 exec, -1
  buffer_store_dwordx4 v[164:167], v172, s[44:47], s100 offen sc1
  buffer_store_dwordx4 v[168:171], v172, s[44:47], s100 offen offset:1024 sc1
  s_mov_b64 exec, s[60:61]
Lnb_q_4:
  s_and_b32 s63, s62, 15
  s_cselect_b32 s56, s98, s40
  s_cselect_b32 s57, s99, s41
  buffer_load_dwordx4 v[24:27], v9, s[56:59], s10 offen sc1
  buffer_load_dwordx4 v[28:31], v9, s[56:59], s10 offen offset:2048 sc1
Lchk_q_3:
  s_waitcnt vmcnt(0)
  v_cmp_ne_u32 vcc, s8, v25
  v_cmp_ne_u32 s[60:61], s8, v27
  s_or_b64 vcc, vcc, s[60:61]
  v_cmp_ne_u32 s[60:61], s8, v29
  s_or_b64 vcc, vcc, s[60:61]
  v_cmp_ne_u32 s[60:61], s8, v31
  s_or_b64 vcc, vcc, s[60:61]
  s_mov_b64 exec, vcc
  s_cbranch_execz Ldone_q_2
  s_sub_u32 s62, s62, 1
  s_cbranch_scc1 Ldone_q_2
  s_sleep 1
  s_branch Lpoll_q_1
Ldone_q_2:
  s_mov_b64 exec, -1
  s_cmp_le_u32 s62, 20012
  s_cbranch_scc1 Lnb_q_5
  s_cmp_eq_u32 s101, 0
  s_cbranch_scc1 Lnb_q_5
  buffer_store_dwordx4 v[164:167], v172, s[44:47], s100 offen sc1
  buffer_store_dwordx4 v[168:171], v172, s[44:47], s100 offen offset:1024 sc1
  s_mov_b64 exec, -1
Lnb_q_5:
  s_lshl_b32 s10, s3, 8
  s_add_u32 s10, s10, 156160
  v_add_f32 v24, v24, v28
  v_add_f32 v26, v26, v30
  v_lshlrev_b32 v9, 2, v0
  v_add_u32 v9, s10, v9
  v_cvt_pk_bf16_f32 v24, v24, v26
  ds_write_b32 v9, v24
  s_waitcnt lgkmcnt(0)
  s_mov_b64 exec, 1
  ds_add_u32 v62, v63 offset:4
  s_mov_b64 exec, -1
  v_xor_b32 v8, v2, v1
  s_lshl_b32 s10, s3, 14
  v_lshl_add_u32 v9, v1, 8, s10
  v_lshl_add_u32 v10, v8, 4, v9
  v_xor_b32 v11, 64, v10
  v_xor_b32 v12, 128, v10
  v_xor_b32 v13, 192, v10
  v_lshlrev_b32 v14, 8, v58
  v_lshl_add_u32 v14, v2, 4, v14
  v_add_u32 v14, 156160, v14
  s_mov_b32 s12, 0x3e0293ee
  v_lshlrev_b32 v36, 6, v2
  v_lshl_add_u32 v36, v58, 4, v36
  s_lshl_b32 s11, s3, 9
  s_add_u32 s11, s11, 158208
  v_add_u32 v37, s11, v36
  v_lshlrev_b32 v38, 5, v58
  s_lshl_b32 s11, s3, 2
  s_add_u32 s11, s11, 155776
  v_add_u32 v39, s11, v38
  s_lshl_b32 s13, s4, 2
  s_add_u32 s13, s13, s6
  s_lshl_b32 s14, s13, 1
  s_bfe_u32 s15, s5, 0x10002
  s_add_u32 s14, s14, s15
  v_min_u32 v8, 13, v1
  s_mul_i32 s10, s14, 28
  v_lshl_add_u32 v9, v8, 1, s10
  v_lshrrev_b32 v59, 6, v9
  v_lshlrev_b32 v59, 12, v59
  v_and_b32 v8, 63, v9
  v_lshl_add_u32 v59, v8, 3, v59
  s_lshl_b32 s10, s3, 9
  s_add_u32 s96, s10, 266240
  s_add_u32 s97, s10, 380928
  s_mov_b32 s62, 160000
Lspin_qk_6:
  ds_read_b32 v61, v62 offset:4
  s_waitcnt lgkmcnt(0)
  v_readfirstlane_b32 s63, v61
  s_cmp_ge_u32 s63, 8
  s_cbranch_scc1 Lsd_qk_7
  s_sub_u32 s62, s62, 1
  s_cbranch_scc1 Lsd_qk_7
  s_sleep 1
  s_branch Lspin_qk_6
Lsd_qk_7:
  ds_read_b128 v[64:67], v14 offset:0
  ds_read_b128 v[68:71], v14 offset:64
  ds_read_b128 v[72:75], v14 offset:128
  ds_read_b128 v[76:79], v14 offset:192
  ds_read_b128 v[80:83], v10 offset:0
  ds_read_b128 v[84:87], v11 offset:0
  ds_read_b128 v[88:91], v12 offset:0
  ds_read_b128 v[92:95], v13 offset:0
  ds_read_b128 v[96:99], v10 offset:4096
  ds_read_b128 v[100:103], v11 offset:4096
  ds_read_b128 v[104:107], v12 offset:4096
  ds_read_b128 v[108:111], v13 offset:4096
  ds_read_b128 v[112:115], v10 offset:8192
  ds_read_b128 v[116:119], v11 offset:8192
  ds_read_b128 v[120:123], v12 offset:8192
  ds_read_b128 v[124:127], v13 offset:8192
  ds_read_b128 v[128:131], v10 offset:12288
  ds_read_b128 v[132:135], v11 offset:12288
  ds_read_b128 v[136:139], v12 offset:12288
  ds_read_b128 v[140:143], v13 offset:12288
  s_waitcnt lgkmcnt(12)
  v_mfma_f32_16x16x32_bf16 v[16:19], v[80:83], v[64:67], 0
  v_mfma_f32_16x16x32_bf16 v[16:19], v[84:87], v[68:71], v[16:19]
  v_mfma_f32_16x16x32_bf16 v[16:19], v[88:91], v[72:75], v[16:19]
  v_mfma_f32_16x16x32_bf16 v[16:19], v[92:95], v[76:79], v[16:19]
  s_waitcnt lgkmcnt(8)
  v_mfma_f32_16x16x32_bf16 v[20:23], v[96:99], v[64:67], 0
  v_mfma_f32_16x16x32_bf16 v[20:23], v[100:103], v[68:71], v[20:23]
  v_mfma_f32_16x16x32_bf16 v[20:23], v[104:107], v[72:75], v[20:23]
  v_mfma_f32_16x16x32_bf16 v[20:23], v[108:111], v[76:79], v[20:23]
  s_waitcnt lgkmcnt(4)
  v_mfma_f32_16x16x32_bf16 v[24:27], v[112:115], v[64:67], 0
  v_mfma_f32_16x16x32_bf16 v[24:27], v[116:119], v[68:71], v[24:27]
  v_mfma_f32_16x16x32_bf16 v[24:27], v[120:123], v[72:75], v[24:27]
  v_mfma_f32_16x16x32_bf16 v[24:27], v[124:127], v[76:79], v[24:27]
  s_waitcnt lgkmcnt(0)
  v_mfma_f32_16x16x32_bf16 v[28:31], v[128:131], v[64:67], 0
  v_mfma_f32_16x16x32_bf16 v[28:31], v[132:135], v[68:71], v[28:31]
  v_mfma_f32_16x16x32_bf16 v[28:31], v[136:139], v[72:75], v[28:31]
  v_mfma_f32_16x16x32_bf16 v[28:31], v[140:143], v[76:79], v[28:31]
  s_mov_b64 exec, 0xffff
  buffer_load_dwordx4 v[144:147], v59, s[44:47], s96 offen sc1
  buffer_load_dwordx4 v[148:151], v59, s[44:47], s96 offen offset:2048 sc1
  buffer_load_dwordx4 v[152:155], v59, s[44:47], s97 offen sc1
  buffer_load_dwordx4 v[156:159], v59, s[44:47], s97 offen offset:2048 sc1
  s_mov_b64 exec, -1
  v_max3_f32 v32, v16, v17, v18
  v_max3_f32 v33, v19, v20, v21
  v_max3_f32 v32, v32, v22, v23
  v_max3_f32 v33, v33, v24, v25
  v_max3_f32 v32, v32, v26, v27
  v_max3_f32 v33, v33, v28, v29
  v_max3_f32 v32, v32, v30, v31
  v_max_f32 v32, v32, v33
  v_mov_b32 v33, v32
  s_nop 1
  v_permlane32_swap_b32 v32, v33
  v_max_f32 v32, v32, v33
  v_mov_b32 v33, v32
  s_nop 1
  v_permlane16_swap_b32 v32, v33
  v_max_f32 v32, v32, v33
  v_mul_f32 v32, s12, v32
  v_fma_f32 v16, v16, s12, -v32
  v_fma_f32 v17, v17, s12, -v32
  v_fma_f32 v18, v18, s12, -v32
  v_fma_f32 v19, v19, s12, -v32
  v_fma_f32 v20, v20, s12, -v32
  v_fma_f32 v21, v21, s12, -v32
  v_fma_f32 v22, v22, s12, -v32
  v_fma_f32 v23, v23, s12, -v32
  v_fma_f32 v24, v24, s12, -v32
  v_fma_f32 v25, v25, s12, -v32
  v_fma_f32 v26, v26, s12, -v32
  v_fma_f32 v27, v27, s12, -v32
  v_fma_f32 v28, v28, s12, -v32
  v_fma_f32 v29, v29, s12, -v32
  v_fma_f32 v30, v30, s12, -v32
  v_fma_f32 v31, v31, s12, -v32
  v_exp_f32 v16, v16
  v_exp_f32 v17, v17
  v_exp_f32 v18, v18
  v_exp_f32 v19, v19
  v_exp_f32 v20, v20
  v_exp_f32 v21, v21
  v_exp_f32 v22, v22
  v_exp_f32 v23, v23
  v_exp_f32 v24, v24
  v_exp_f32 v25, v25
  v_exp_f32 v26, v26
  v_exp_f32 v27, v27
  v_exp_f32 v28, v28
  v_exp_f32 v29, v29
  v_exp_f32 v30, v30
  v_exp_f32 v31, v31
  v_cvt_pk_bf16_f32 v40, v16, v17
  v_cvt_pk_bf16_f32 v41, v18, v19
  v_cvt_pk_bf16_f32 v42, v20, v21
  v_cvt_pk_bf16_f32 v43, v22, v23
  v_cvt_pk_bf16_f32 v44, v24, v25
  v_cvt_pk_bf16_f32 v45, v26, v27
  v_cvt_pk_bf16_f32 v46, v28, v29
  v_cvt_pk_bf16_f32 v47, v30, v31
  v_add_f32 v16, v16, v17
  v_add_f32 v18, v18, v19
  v_add_f32 v20, v20, v21
  v_add_f32 v22, v22, v23
  v_add_f32 v24, v24, v25
  v_add_f32 v26, v26, v27
  v_add_f32 v28, v28, v29
  v_add_f32 v30, v30, v31
  v_add_f32 v16, v16, v18
  v_add_f32 v20, v20, v22
  v_add_f32 v24, v24, v26
  v_add_f32 v28, v28, v30
  v_add_f32 v16, v16, v20
  v_add_f32 v24, v24, v28
  v_add_f32 v33, v16, v24
  v_mov_b32 v34, v33
  s_mov_b32 exec_lo, 0x11111111
  s_mov_b32 exec_hi, 0x11111111
  ds_write_b128 v37, v[40:43]
  ds_write_b128 v37, v[44:47] offset:256
  s_mov_b64 exec, -1
  v_permlane32_swap_b32 v33, v34
  v_add_f32 v33, v33, v34
  v_mov_b32 v34, v33
  s_nop 1
  v_permlane16_swap_b32 v33, v34
  v_add_f32 v33, v33, v34
  s_mov_b64 exec, 0x1111
  ds_write_b32 v39, v32
  ds_write_b32 v39, v33 offset:16
  s_mov_b64 exec, -1
  s_waitcnt lgkmcnt(0)
  s_mov_b64 exec, 1
  ds_add_u32 v62, v63 offset:16
  s_mov_b64 exec, -1
  v_add_u32 v36, 158208, v36
  v_lshlrev_b32 v38, 5, v2
  v_add_u32 v38, 155776, v38
  v_lshl_add_u32 v9, v2, 2, v58
  v_and_b32 v10, 7, v9
  v_lshlrev_b32 v10, 1, v10
  v_lshrrev_b32 v11, 1, v3
  s_lshl_b32 s10, s3, 2
  v_add_u32 v11, s10, v11
  v_xor_b32 v10, v10, v11
  v_lshlrev_b32 v10, 4, v10
  v_lshl_add_u32 v10, v9, 8, v10
  v_and_b32 v11, 1, v3
  v_lshl_add_u32 v10, v11, 3, v10
  v_add_u32 v12, 65536, v10
  v_xor_b32 v13, 32, v12
  v_add_u32 v6, 131072, v10
  v_xor_b32 v7, 32, v6
  s_lshl_b32 s10, s4, 4
  s_add_u32 s10, s10, s6
  s_lshl_b32 s10, s10, 3
  s_add_u32 s10, s10, s7
  v_lshlrev_b32 v160, 14, v2
  v_and_b32 v15, 1, v1
  v_lshl_add_u32 v160, v15, 6, v160
  v_lshrrev_b32 v15, 1, v1
  v_lshl_add_u32 v160, v15, 3, v160
  s_lshl_b32 s94, s10, 9
  s_lshl_b32 s12, s3, 7
  s_add_u32 s94, s94, s12
  s_add_u32 s94, s94, 589824
  v_lshlrev_b32 v161, 11, v2
  v_lshl_add_u32 v161, v1, 3, v161
  s_lshl_b32 s95, s10, 6
  s_add_u32 s95, s95, 2162688
  s_lshl_b32 s12, s3, 4
  s_mov_b64 s[86:87], 0xff
  s_lshl_b64 s[86:87], s[86:87], s12
  s_mov_b32 s42, 0xAAAAAAAA
  s_mov_b32 s43, 0xAAAAAAAA
  s_lshl_b32 s10, s13, 2
  s_add_u32 s10, s10, s3
  s_lshl_b32 s11, s10, 12
  s_lshl_b32 s12, s15, 8
  s_add_u32 s11, s11, s12
  s_add_u32 s11, s11, 589824
  s_lshl_b32 s12, s10, 9
  s_add_u32 s12, s12, 2162744
  v_lshlrev_b32 v173, 4, v1
  v_lshl_add_u32 v173, v2, 10, v173
  v_lshlrev_b32 v174, 7, v2
  v_lshrrev_b32 v175, 3, v1
  v_lshlrev_b32 v175, 8, v175
  v_lshl_add_u32 v175, v3, 4, v175
  v_bfe_u32 v15, v1, 2, 1
  v_lshl_add_u32 v175, v15, 3, v175
  s_lshl_b32 s10, s3, 6
  s_add_u32 s10, s10, 162304
  v_add_u32 v175, s10, v175
  s_mov_b32 s62, 160000
Lspin_p_8:
  ds_read_b32 v61, v62 offset:16
  s_waitcnt lgkmcnt(0)
  v_readfirstlane_b32 s63, v61
  s_cmp_ge_u32 s63, 4
  s_cbranch_scc1 Lsd_p_9
  s_sub_u32 s62, s62, 1
  s_cbranch_scc1 Lsd_p_9
  s_sleep 1
  s_branch Lspin_p_8
Lsd_p_9:
  ds_read_b128 v[64:67], v36 offset:0
  ds_read_b128 v[68:71], v36 offset:256
  ds_read_b128 v[72:75], v36 offset:512
  ds_read_b128 v[76:79], v36 offset:768
  ds_read_b128 v[80:83], v36 offset:1024
  ds_read_b128 v[84:87], v36 offset:1280
  ds_read_b128 v[88:91], v36 offset:1536
  ds_read_b128 v[92:95], v36 offset:1792
  ds_read_b128 v[48:51], v38
  ds_read_b128 v[52:55], v38 offset:16
  s_waitcnt lgkmcnt(0)
  v_max3_f32 v56, v48, v49, v50
  v_max_f32 v56, v56, v51
  v_sub_f32 v48, v48, v56
  v_sub_f32 v49, v49, v56
  v_sub_f32 v50, v50, v56
  v_sub_f32 v51, v51, v56
  v_exp_f32 v48, v48
  v_exp_f32 v49, v49
  v_exp_f32 v50, v50
  v_exp_f32 v51, v51
  s_nop 0
  v_mul_f32 v57, v48, v52
  v_fmac_f32 v57, v49, v53
  v_fmac_f32 v57, v50, v54
  v_fmac_f32 v57, v51, v55
  v_rcp_f32 v55, v57
  v_log_f32 v162, v57
  v_mov_b32 v163, s8
  v_mov_b32 v133, s8
  v_mul_f32 v48, v48, v55
  v_mul_f32 v49, v49, v55
  v_mul_f32 v50, v50, v55
  v_mul_f32 v51, v51, v55
  v_add_f32 v162, v162, v56
  s_mov_b32 s62, 160000
Lspin_va_10:
  ds_read_b32 v61, v62 offset:8
  s_waitcnt lgkmcnt(0)
  v_readfirstlane_b32 s63, v61
  s_cmp_ge_u32 s63, 4
  s_cbranch_scc1 Lsd_va_11
  s_sub_u32 s62, s62, 1
  s_cbranch_scc1 Lsd_va_11
  s_sleep 1
  s_branch Lspin_va_10
Lsd_va_11:
  ds_read_b64_tr_b16 v[96:97], v12 offset:0
  ds_read_b64_tr_b16 v[98:99], v12 offset:4096
  ds_read_b64_tr_b16 v[100:101], v12 offset:8192
  ds_read_b64_tr_b16 v[102:103], v12 offset:12288
  ds_read_b64_tr_b16 v[104:105], v12 offset:16384
  ds_read_b64_tr_b16 v[106:107], v12 offset:20480
  ds_read_b64_tr_b16 v[108:109], v12 offset:24576
  ds_read_b64_tr_b16 v[110:111], v12 offset:28672
  ds_read_b64_tr_b16 v[112:113], v13 offset:0
  ds_read_b64_tr_b16 v[114:115], v13 offset:4096
  ds_read_b64_tr_b16 v[116:117], v13 offset:8192
  ds_read_b64_tr_b16 v[118:119], v13 offset:12288
  ds_read_b64_tr_b16 v[120:121], v13 offset:16384
  ds_read_b64_tr_b16 v[122:123], v13 offset:20480
  ds_read_b64_tr_b16 v[124:125], v13 offset:24576
  ds_read_b64_tr_b16 v[126:127], v13 offset:28672
  s_waitcnt lgkmcnt(14)
  v_mfma_f32_16x16x32_bf16 v[16:19], v[64:67], v[96:99], 0
  s_waitcnt lgkmcnt(12)
  v_mfma_f32_16x16x32_bf16 v[16:19], v[68:71], v[100:103], v[16:19]
  s_waitcnt lgkmcnt(10)
  v_mfma_f32_16x16x32_bf16 v[20:23], v[72:75], v[104:107], 0
  s_waitcnt lgkmcnt(8)
  v_mfma_f32_16x16x32_bf16 v[20:23], v[76:79], v[108:111], v[20:23]
  s_waitcnt lgkmcnt(6)
  v_mfma_f32_16x16x32_bf16 v[32:35], v[64:67], v[112:115], 0
  s_waitcnt lgkmcnt(4)
  v_mfma_f32_16x16x32_bf16 v[32:35], v[68:71], v[116:119], v[32:35]
  s_waitcnt lgkmcnt(2)
  v_mfma_f32_16x16x32_bf16 v[36:39], v[72:75], v[120:123], 0
  s_waitcnt lgkmcnt(0)
  v_mfma_f32_16x16x32_bf16 v[36:39], v[76:79], v[124:127], v[36:39]
  s_nop 7
  v_mul_f32 v128, v48, v16
  v_mul_f32 v129, v48, v32
  v_fmac_f32 v128, v49, v20
  v_fmac_f32 v129, v49, v36
  s_mov_b32 s62, 20015
  s_mov_b64 exec, 0xffff
  s_branch Lchk_h_14
Lpoll_h_12:
  buffer_load_dwordx4 v[144:147], v59, s[44:47], s96 offen sc1
  buffer_load_dwordx4 v[148:151], v59, s[44:47], s96 offen offset:2048 sc1
  buffer_load_dwordx4 v[152:155], v59, s[44:47], s97 offen sc1
  buffer_load_dwordx4 v[156:159], v59, s[44:47], s97 offen offset:2048 sc1
Lchk_h_14:
  s_waitcnt vmcnt(0)
  v_cmp_ne_u32 vcc, s8, v145
  v_cmp_ne_u32 s[60:61], s8, v147
  s_or_b64 vcc, vcc, s[60:61]
  v_cmp_ne_u32 s[60:61], s8, v149
  s_or_b64 vcc, vcc, s[60:61]
  v_cmp_ne_u32 s[60:61], s8, v151
  s_or_b64 vcc, vcc, s[60:61]
  v_cmp_ne_u32 s[60:61], s8, v153
  s_or_b64 vcc, vcc, s[60:61]
  v_cmp_ne_u32 s[60:61], s8, v155
  s_or_b64 vcc, vcc, s[60:61]
  v_cmp_ne_u32 s[60:61], s8, v157
  s_or_b64 vcc, vcc, s[60:61]
  v_cmp_ne_u32 s[60:61], s8, v159
  s_or_b64 vcc, vcc, s[60:61]
  s_mov_b64 exec, vcc
  s_cbranch_execz Ldone_h_13
  s_sub_u32 s62, s62, 1
  s_cbranch_scc1 Ldone_h_13
  s_sleep 4
  s_branch Lpoll_h_12
Ldone_h_13:
  s_mov_b64 exec, -1
  v_add_f32 v16, v144, v148
  v_add_f32 v17, v146, v150
  v_add_f32 v18, v152, v156
  v_add_f32 v19, v154, v158
  v_mul_f32 v20, 0xbfb8aa3b, v16
  v_mul_f32 v21, 0xbfb8aa3b, v17
  v_exp_f32 v20, v20
  v_exp_f32 v21, v21
  v_mul_f32 v16, v16, v18
  v_add_f32 v20, 1.0, v20
  v_add_f32 v21, 1.0, v21
  v_rcp_f32 v20, v20
  v_rcp_f32 v21, v21
  v_mul_f32 v17, v17, v19
  v_mul_f32 v16, v16, v20
  v_mul_f32 v17, v17, v21
  v_cvt_pk_bf16_f32 v16, v16, v17
  v_cmp_gt_u32 vcc, 14, v1
  v_bfe_u32 v23, v1, 1, 2
  v_lshlrev_b32 v22, 4, v23
  v_lshrrev_b32 v23, 3, v1
  v_lshl_add_u32 v22, v23, 3, v22
  v_and_b32 v23, 1, v1
  v_lshl_add_u32 v22, v23, 2, v22
  s_lshl_b32 s10, s3, 6
  s_add_u32 s10, s10, 162816
  v_add_u32 v22, s10, v22
  v_cndmask_b32 v16, 0, v16, vcc
  s_mov_b64 exec, 0xffff
  ds_write_b32 v22, v16
  s_mov_b64 exec, -1
  v_lshlrev_b32 v8, 6, v58
  v_lshl_add_u32 v8, v2, 4, v8
  v_add_u32 v9, 162304, v8
  v_lshlrev_b32 v10, 2, v2
  v_add_u32 v10, 155680, v10
  v_lshlrev_b32 v14, 18, v2
  v_lshrrev_b32 v15, 3, v1
  v_lshl_add_u32 v14, v15, 12, v14
  v_and_b32 v15, 7, v1
  v_lshl_add_u32 v14, v15, 3, v14
  s_and_b32 s9, s5, 3
  s_lshl_b32 s10, s9, 4
  s_lshl_b32 s9, s3, 2
  s_add_u32 s10, s10, s9
  s_lshl_b32 s10, s10, 12
  s_lshl_b32 s9, s14, 6
  s_add_u32 s10, s10, s9
  s_add_u32 s92, s10, 1114112
  s_add_u32 s93, s92, 8192
  s_mov_b32 s62, 160000
Lspin_vb_17:
  ds_read_b32 v61, v62 offset:12
  s_waitcnt lgkmcnt(0)
  v_readfirstlane_b32 s63, v61
  s_cmp_ge_u32 s63, 4
  s_cbranch_scc1 Lsd_vb_18
  s_sub_u32 s62, s62, 1
  s_cbranch_scc1 Lsd_vb_18
  s_sleep 1
  s_branch Lspin_vb_17
Lsd_vb_18:
  ds_read_b64_tr_b16 v[96:97], v12 offset:32768
  ds_read_b64_tr_b16 v[98:99], v12 offset:36864
  ds_read_b64_tr_b16 v[100:101], v12 offset:40960
  ds_read_b64_tr_b16 v[102:103], v12 offset:45056
  ds_read_b64_tr_b16 v[104:105], v12 offset:49152
  ds_read_b64_tr_b16 v[106:107], v12 offset:53248
  ds_read_b64_tr_b16 v[108:109], v12 offset:57344
  ds_read_b64_tr_b16 v[110:111], v12 offset:61440
  ds_read_b64_tr_b16 v[112:113], v13 offset:32768
  ds_read_b64_tr_b16 v[114:115], v13 offset:36864
  ds_read_b64_tr_b16 v[116:117], v13 offset:40960
  ds_read_b64_tr_b16 v[118:119], v13 offset:45056
  ds_read_b64_tr_b16 v[120:121], v13 offset:49152
  ds_read_b64_tr_b16 v[122:123], v13 offset:53248
  ds_read_b64_tr_b16 v[124:125], v13 offset:57344
  ds_read_b64_tr_b16 v[126:127], v13 offset:61440
  s_waitcnt lgkmcnt(14)
  v_mfma_f32_16x16x32_bf16 v[24:27], v[80:83], v[96:99], 0
  s_waitcnt lgkmcnt(12)
  v_mfma_f32_16x16x32_bf16 v[24:27], v[84:87], v[100:103], v[24:27]
  s_waitcnt lgkmcnt(10)
  v_mfma_f32_16x16x32_bf16 v[28:31], v[88:91], v[104:107], 0
  s_waitcnt lgkmcnt(8)
  v_mfma_f32_16x16x32_bf16 v[28:31], v[92:95], v[108:111], v[28:31]
  s_waitcnt lgkmcnt(6)
  v_mfma_f32_16x16x32_bf16 v[40:43], v[80:83], v[112:115], 0
  s_waitcnt lgkmcnt(4)
  v_mfma_f32_16x16x32_bf16 v[40:43], v[84:87], v[116:119], v[40:43]
  s_waitcnt lgkmcnt(2)
  v_mfma_f32_16x16x32_bf16 v[44:47], v[88:91], v[120:123], 0
  s_waitcnt lgkmcnt(0)
  v_mfma_f32_16x16x32_bf16 v[44:47], v[92:95], v[124:127], v[44:47]
  s_nop 6
  v_fmac_f32 v128, v50, v24
  v_fmac_f32 v129, v50, v40
  v_fmac_f32 v128, v51, v28
  v_fmac_f32 v129, v51, v44
  s_nop 0
  v_mov_b32_dpp v130, v128 quad_perm:[1,0,3,2] row_mask:0xf bank_mask:0xf
  v_mov_b32_dpp v131, v129 quad_perm:[1,0,3,2] row_mask:0xf bank_mask:0xf
  v_cvt_pk_bf16_f32 v130, v128, v130
  v_cvt_pk_bf16_f32 v131, v131, v129
  v_cndmask_b32 v132, v130, v131, s[42:43]
  buffer_store_dwordx2 v[132:133], v160, s[52:55], s94 offen
  s_mov_b64 exec, s[86:87]
  buffer_store_dwordx2 v[162:163], v161, s[52:55], s95 offen
  s_mov_b64 exec, -1
  s_mov_b32 s62, 20015
  s_sleep 3
Lpoll_o_19:
  s_cmp_lg_u32 s62, 20005
  s_cbranch_scc1 Lnb_o_22
  s_mov_b64 s[60:61], exec
  s_mov_b64 exec, -1
  buffer_store_dwordx2 v[132:133], v160, s[44:47], s94 offen sc1
  s_mov_b64 exec, s[86:87]
  buffer_store_dwordx2 v[162:163], v161, s[44:47], s95 offen sc1
  s_mov_b64 exec, s[60:61]
Lnb_o_22:
  s_and_b32 s63, s62, 15
  s_cselect_b32 s56, s98, s40
  s_cselect_b32 s57, s99, s41
  buffer_load_dwordx4 v[64:67], v173, s[56:59], s11 offen offset:0 sc1
  buffer_load_dwordx4 v[68:71], v173, s[56:59], s11 offen offset:512 sc1
  buffer_load_dwordx4 v[72:75], v174, s[56:59], s12 offen sc1
Lchk_o_21:
  s_waitcnt vmcnt(0)
  v_cmp_ne_u32 vcc, s8, v65
  v_cmp_ne_u32 s[60:61], s8, v67
  s_or_b64 vcc, vcc, s[60:61]
  v_cmp_ne_u32 s[60:61], s8, v69
  s_or_b64 vcc, vcc, s[60:61]
  v_cmp_ne_u32 s[60:61], s8, v71
  s_or_b64 vcc, vcc, s[60:61]
  v_cmp_ne_u32 s[60:61], s8, v73
  s_or_b64 vcc, vcc, s[60:61]
  v_cmp_ne_u32 s[60:61], s8, v75
  s_or_b64 vcc, vcc, s[60:61]
  s_mov_b64 exec, vcc
  s_cbranch_execz Ldone_o_20
  s_sub_u32 s62, s62, 1
  s_cbranch_scc1 Ldone_o_20
  s_sleep 1
  s_branch Lpoll_o_19
Ldone_o_20:
  s_mov_b64 exec, -1
  s_cmp_le_u32 s62, 20005
  s_cbranch_scc1 Lnb_o_23
  buffer_store_dwordx2 v[132:133], v160, s[44:47], s94 offen sc1
  s_mov_b64 exec, s[86:87]
  buffer_store_dwordx2 v[162:163], v161, s[44:47], s95 offen sc1
  s_mov_b64 exec, -1
Lnb_o_23:
  v_max_f32 v16, v72, v74
  v_lshlrev_b32 v40, 16, v64
  v_mov_b32 v17, v16
  v_and_b32 v41, 0xffff0000, v64
  v_lshlrev_b32 v42, 16, v66
  v_permlane32_swap_b32 v16, v17
  v_and_b32 v43, 0xffff0000, v66
  v_max_f32 v16, v16, v17
  v_lshlrev_b32 v44, 16, v68
  v_mov_b32 v17, v16
  v_and_b32 v45, 0xffff0000, v68
  v_lshlrev_b32 v46, 16, v70
  v_permlane16_swap_b32 v16, v17
  v_and_b32 v47, 0xffff0000, v70
  v_max_f32 v16, v16, v17
  v_sub_f32 v72, v72, v16
  v_sub_f32 v74, v74, v16
  v_exp_f32 v72, v72
  v_exp_f32 v74, v74
  v_mov_b32 v29, s8
  v_mul_f32 v18, v72, v40
  v_mul_f32 v19, v72, v41
  v_mul_f32 v20, v72, v42
  v_mul_f32 v21, v72, v43
  v_add_f32 v16, v72, v74
  v_fmac_f32 v18, v74, v44
  v_fmac_f32 v19, v74, v45
  v_fmac_f32 v20, v74, v46
  v_fmac_f32 v21, v74, v47
  v_mov_b32 v17, v16
  v_mov_b32 v24, v18
  v_mov_b32 v25, v19
  v_mov_b32 v26, v20
  v_mov_b32 v27, v21
  v_permlane32_swap_b32 v16, v17
  v_permlane32_swap_b32 v18, v24
  v_permlane32_swap_b32 v19, v25
  v_permlane32_swap_b32 v20, v26
  v_permlane32_swap_b32 v21, v27
  v_add_f32 v16, v16, v17
  v_add_f32 v18, v18, v24
  v_add_f32 v19, v19, v25
  v_add_f32 v20, v20, v26
  v_add_f32 v21, v21, v27
  v_mov_b32 v17, v16
  v_mov_b32 v24, v18
  v_mov_b32 v25, v19
  v_mov_b32 v26, v20
  v_mov_b32 v27, v21
  v_permlane16_swap_b32 v16, v17
  v_permlane16_swap_b32 v18, v24
  v_permlane16_swap_b32 v19, v25
  v_permlane16_swap_b32 v20, v26
  v_permlane16_swap_b32 v21, v27
  v_add_f32 v16, v16, v17
  v_add_f32 v18, v18, v24
  v_rcp_f32 v16, v16
  v_add_f32 v19, v19, v25
  v_add_f32 v20, v20, v26
  v_add_f32 v21, v21, v27
  v_mul_f32 v18, v18, v16
  v_mul_f32 v19, v19, v16
  v_mul_f32 v20, v20, v16
  v_mul_f32 v21, v21, v16
  v_cvt_pk_bf16_f32 v18, v18, v19
  v_cvt_pk_bf16_f32 v19, v20, v21
  ds_write_b64 v175, v[18:19]
  v_mov_b32 v31, s8
  s_waitcnt lgkmcnt(0)
  s_barrier
  ds_read_b128 v[64:67], v9
  ds_read_b128 v[68:71], v9 offset:256
  ds_read_b128 v[72:75], v9 offset:512
  ds_read_b32 v11, v10
  ds_read_b64_tr_b16 v[96:97], v6 offset:0
  ds_read_b64_tr_b16 v[98:99], v6 offset:4096
  ds_read_b64_tr_b16 v[100:101], v6 offset:8192
  ds_read_b64_tr_b16 v[102:103], v6 offset:12288
  ds_read_b64_tr_b16 v[104:105], v6 offset:16384
  ds_read_b64_tr_b16 v[106:107], v6 offset:20480
  ds_read_b64_tr_b16 v[108:109], v7 offset:0
  ds_read_b64_tr_b16 v[110:111], v7 offset:4096
  ds_read_b64_tr_b16 v[112:113], v7 offset:8192
  ds_read_b64_tr_b16 v[114:115], v7 offset:12288
  ds_read_b64_tr_b16 v[116:117], v7 offset:16384
  ds_read_b64_tr_b16 v[118:119], v7 offset:20480
  s_waitcnt lgkmcnt(6)
  v_mfma_f32_16x16x32_bf16 v[20:23], v[72:75], v[104:107], 0
  v_mfma_f32_16x16x32_bf16 v[16:19], v[64:67], v[96:99], 0
  v_mfma_f32_16x16x32_bf16 v[16:19], v[68:71], v[100:103], v[16:19]
  s_waitcnt lgkmcnt(0)
  v_mfma_f32_16x16x32_bf16 v[44:47], v[72:75], v[116:119], 0
  v_mfma_f32_16x16x32_bf16 v[40:43], v[64:67], v[108:111], 0
  v_mfma_f32_16x16x32_bf16 v[40:43], v[68:71], v[112:115], v[40:43]
  v_sub_f32 v12, 1.0, v11
  s_nop 3
  v_mul_f32 v20, v20, v12
  v_fma_f32 v28, v16, v11, v20
  buffer_store_dwordx2 v[28:29], v14, s[44:47], s92 offen sc1
  v_mul_f32 v44, v44, v12
  s_nop 0
  v_fma_f32 v30, v40, v11, v44
  buffer_store_dwordx2 v[30:31], v14, s[44:47], s93 offen sc1
  s_cmp_lg_u32 s3, 0
  s_cbranch_scc1 L_FIN
  s_lshl_b32 s10, s2, 12
  s_add_u32 s10, s10, 1114112
  v_lshlrev_b32 v8, 4, v0
  s_mov_b32 s48, s36
  s_mov_b32 s49, s37
  s_mov_b32 s50, 4096
  s_mov_b32 s62, 20015
  s_sleep 24
Lpoll_y_24:
  buffer_load_dwordx4 v[64:67], v8, s[44:47], s10 offen offset:0 sc1
  buffer_load_dwordx4 v[68:71], v8, s[44:47], s10 offen offset:1024 sc1
  buffer_load_dwordx4 v[72:75], v8, s[44:47], s10 offen offset:2048 sc1
  buffer_load_dwordx4 v[76:79], v8, s[44:47], s10 offen offset:3072 sc1
Lchk_y_26:
  s_waitcnt vmcnt(0)
  v_cmp_ne_u32 vcc, s8, v65
  v_cmp_ne_u32 s[60:61], s8, v67
  s_or_b64 vcc, vcc, s[60:61]
  v_cmp_ne_u32 s[60:61], s8, v69
  s_or_b64 vcc, vcc, s[60:61]
  v_cmp_ne_u32 s[60:61], s8, v71
  s_or_b64 vcc, vcc, s[60:61]
  v_cmp_ne_u32 s[60:61], s8, v73
  s_or_b64 vcc, vcc, s[60:61]
  v_cmp_ne_u32 s[60:61], s8, v75
  s_or_b64 vcc, vcc, s[60:61]
  v_cmp_ne_u32 s[60:61], s8, v77
  s_or_b64 vcc, vcc, s[60:61]
  v_cmp_ne_u32 s[60:61], s8, v79
  s_or_b64 vcc, vcc, s[60:61]
  s_mov_b64 exec, vcc
  s_cbranch_execz Ldone_y_25
  s_sub_u32 s62, s62, 1
  s_cbranch_scc1 Ldone_y_25
  s_sleep 1
  s_branch Lpoll_y_24
Ldone_y_25:
  s_mov_b64 exec, -1
  v_add_f32 v16, v64, v68
  v_add_f32 v17, v66, v70
  v_add_f32 v18, v72, v76
  v_add_f32 v19, v74, v78
  v_add_f32 v16, v16, v18
  v_add_f32 v17, v17, v19
  v_lshlrev_b32 v8, 2, v0
  s_lshl_b32 s10, s2, 4
  v_add_f32_dpp v16, v16, v16 row_ror:4 row_mask:0xf bank_mask:0xf
  v_add_f32_dpp v17, v17, v17 row_ror:4 row_mask:0xf bank_mask:0xf
  s_nop 1
  v_add_f32_dpp v16, v16, v16 row_ror:8 row_mask:0xf bank_mask:0xf
  v_add_f32_dpp v17, v17, v17 row_ror:8 row_mask:0xf bank_mask:0xf
  v_mov_b32 v18, v16
  v_mov_b32 v19, v17
  s_nop 1
  v_permlane16_swap_b32 v16, v18
  v_permlane16_swap_b32 v17, v19
  v_add_f32 v16, v16, v18
  v_add_f32 v17, v17, v19
  v_mov_b32 v18, v16
  v_mov_b32 v19, v17
  s_nop 1
  v_permlane32_swap_b32 v16, v18
  v_permlane32_swap_b32 v17, v19
  v_add_f32 v16, v16, v18
  v_add_f32 v17, v17, v19
  v_cvt_pk_bf16_f32 v16, v16, v17
  s_mov_b64 exec, 15
  buffer_store_dword v16, v8, s[48:51], s10 offen sc1
  s_cmp_lg_u32 s2, 0
  s_cbranch_scc1 L_FIN
  s_mov_b64 exec, 1
  v_add_u32 v5, 1, v5
  buffer_store_dword v5, v4, s[44:47], 0 offen sc1
  s_branch L_FIN
L_GB:
  s_sub_u32 s9, s3, 4
  s_lshl_b32 s10, s6, 3
  s_add_u32 s10, s10, s4
  s_lshl_b32 s10, s10, 21
  s_lshl_b32 s11, s7, 16
  s_add_u32 s13, s10, s11
  s_add_u32 s13, s13, 1572864
  s_mov_b32 s50, 65536
  s_mov_b32 s54, 65536
  s_mul_i32 s10, s2, 5
  s_add_u32 s10, s10, s9
  s_and_b32 s10, s10, 63
  s_and_b32 s11, s10, 3
  s_lshl_b32 s11, s11, 2
  v_add_u32 v6, s11, v2
  v_xor_b32 v6, v6, v1
  v_lshlrev_b32 v6, 4, v6
  v_lshl_add_u32 v6, v2, 8, v6
  s_and_b32 s11, s10, 1
  s_lshl_b32 s11, s11, 2
  v_add_u32 v7, s11, v2
  v_lshlrev_b32 v7, 1, v7
  v_xor_b32 v7, v7, v1
  v_lshlrev_b32 v7, 4, v7
  v_lshl_add_u32 v7, v2, 8, v7
  v_mov_b32 v8, 0
  v_mov_b32 v9, 0
  v_mov_b32 v10, 0
  v_mov_b32 v11, 0
  ds_write_b128 v62, v[8:11]
  ds_write_b128 v62, v[8:11] offset:16
  v_mov_b32 v60, 155652
  s_mov_b32 s12, 16
  s_and_b32 s42, s5, 30
  s_cmp_eq_u32 s42, 6
  s_cselect_b32 s42, 12, 15
  s_waitcnt lgkmcnt(0)
  s_add_u32 s48, s18, s13
  s_addc_u32 s49, s19, 0
  s_add_u32 s52, s20, s13
  s_addc_u32 s53, s21, 0

L_KL:
  s_lshl_b32 s11, s10, 10
  s_mov_b32 m0, s11
  s_add_u32 s10, s10, 4
  s_and_b32 s10, s10, 63
  s_waitcnt vmcnt(4)
  buffer_load_dwordx4 v6, s[48:51], s11 offen nt lds
  s_sub_u32 s12, s12, 1
  s_cmp_lg_u32 s12, s42
  s_cbranch_scc1 L_KL2
  s_barrier
L_KL2:
  s_cmp_lg_u32 s12, 0
  s_cbranch_scc1 L_KL
  s_and_b32 s10, s10, 31
  s_mov_b32 s13, 0
  s_mov_b32 s12, 0
  s_mov_b32 s15, 6
  s_lshl_b32 s14, s4, 2
  s_add_u32 s14, s14, s6
  s_lshl_b32 s14, s14, 1
  s_bfe_u32 s11, s5, 0x10002
  s_add_u32 s14, s14, s11
  s_and_b32 s11, s5, 3
  s_lshl_b32 s11, s11, 8
  s_lshl_b32 s16, s14, 16
  s_add_u32 s16, s16, s11
  s_add_u32 s48, s24, s16
  s_addc_u32 s49, s25, 0
  s_sub_u32 s50, 4194304, s16
  s_mul_i32 s16, s14, 28672
  s_add_u32 s16, s16, s11
  s_add_u32 s56, s32, s16
  s_addc_u32 s57, s33, 0
  s_sub_u32 s58, 1835008, s16
  s_mov_b32 s59, 0x00020000
  v_lshlrev_b32 v8, 1, v2
  v_xor_b32 v8, v8, v1
  v_lshlrev_b32 v8, 4, v8
  v_lshl_add_u32 v8, v2, 10, v8
  v_xor_b32 v9, 0x80, v8
L_VL:
  s_cmp_lg_u32 s12, 8
  s_cbranch_scc1 L_V1
  s_mov_b32 s62, 160000
Lspin_p1_29:
  ds_read_b32 v61, v62 offset:0
  s_waitcnt lgkmcnt(0)
  v_readfirstlane_b32 s63, v61
  s_cmp_ge_u32 s63, 4
  s_cbranch_scc1 Lsd_p1_30
  s_sub_u32 s62, s62, 1
  s_cbranch_scc1 Lsd_p1_30
  s_sleep 1
  s_branch Lspin_p1_29
Lsd_p1_30:
  s_mov_b32 s13, 32768
L_V1:
  s_lshl_b32 s11, s10, 10
  s_add_u32 s11, s11, s13
  s_add_u32 m0, s11, 65536
  s_add_u32 s10, s10, 4
  s_and_b32 s10, s10, 31
  s_waitcnt vmcnt(6)
  s_cmp_lg_u32 s12, s15
  s_cbranch_scc1 L_V2
  s_mov_b64 exec, 1
  ds_add_u32 v60, v63
  s_mov_b64 exec, -1
  v_add_u32 v60, 4, v60
  s_mov_b32 s15, 14
  s_cmp_eq_u32 s12, 14
  s_cselect_b32 s15, 99, s15
L_V2:
  buffer_load_dwordx4 v7, s[52:55], s11 offen nt lds
  s_add_u32 s12, s12, 1
  s_cmp_lt_u32 s12, 16
  s_cbranch_scc1 L_VL
  s_lshl_b32 s10, s9, 14
  s_lshl_b32 s11, s9, 12
  s_add_u32 s11, s11, 131072
  s_add_u32 m0, s11, 0
  s_add_u32 s12, s10, 0
  s_waitcnt vmcnt(6)
  buffer_load_dwordx4 v8, s[48:51], s12 offen nt lds
  s_add_u32 m0, s11, 1024
  s_add_u32 s12, s10, 4096
  s_waitcnt vmcnt(6)
  buffer_load_dwordx4 v9, s[48:51], s12 offen nt lds
  s_add_u32 m0, s11, 2048
  s_add_u32 s12, s10, 8192
  s_waitcnt vmcnt(6)
  buffer_load_dwordx4 v8, s[48:51], s12 offen nt lds
  s_add_u32 m0, s11, 3072
  s_add_u32 s12, s10, 12288
  s_waitcnt vmcnt(6)
  buffer_load_dwordx4 v9, s[48:51], s12 offen nt lds
  s_lshl_b32 s10, s9, 13
  s_lshl_b32 s11, s9, 11
  s_add_u32 s11, s11, 147456
  s_add_u32 m0, s11, 0
  s_add_u32 s12, s10, 0
  s_min_u32 s12, s12, 24576
  s_waitcnt vmcnt(6)
  buffer_load_dwordx4 v8, s[56:59], s12 offen nt lds
  s_add_u32 m0, s11, 1024
  s_add_u32 s12, s10, 4096
  s_min_u32 s12, s12, 24576
  s_waitcnt vmcnt(6)
  buffer_load_dwordx4 v9, s[56:59], s12 offen nt lds
  s_waitcnt vmcnt(6)
  s_mov_b64 exec, 1
  ds_add_u32 v62, v63 offset:12
  s_mov_b64 exec, -1
  s_waitcnt vmcnt(0)
L_FIN:
L_end:
  s_endpgm

.section .rodata,"a"
.p2align 6
.amdhsa_kernel gated_mix__sliding_block_cached__glu_gated_swiglu__decode_kernel
  .amdhsa_next_free_vgpr 176
  .amdhsa_next_free_sgpr 102
  .amdhsa_accum_offset 176
  .amdhsa_group_segment_fixed_size 0
  .amdhsa_kernarg_size 104
  .amdhsa_user_sgpr_count 2
  .amdhsa_user_sgpr_kernarg_segment_ptr 1
  .amdhsa_system_sgpr_workgroup_id_x 1
.end_amdhsa_kernel
```
